```python
import torch

def _softmax(x, axis=-1):
    return torch.softmax(x, dim=axis)
def _gelu(x):
    return torch.nn.functional.gelu(x, approximate="tanh")
def _silu(x):
    return torch.nn.functional.silu(x)
def _sigmoid(x):
    return torch.sigmoid(x)
def _layernorm(x, axis=-1, eps=1e-5):
    m = x.mean(dim=axis, keepdim=True)
    v = x.var(dim=axis, keepdim=True, unbiased=False)
    return (x - m) / torch.sqrt(v + eps)
def _scatter_add(tgt, idx, src, axis=0):
    return tgt.clone().index_add_(axis, idx, src)
def _segment_sum(src, seg, n):
    out = torch.zeros((n,) + src.shape[1:], dtype=src.dtype)
    return out.index_add_(0, seg, src)
def _pad(x, pw):
    flat = tuple(v for pair in reversed(pw) for v in pair)
    return torch.nn.functional.pad(x, flat)

kernel_name = 'standalone__batchnorm__sampling'

def setup_inputs():

    _w = (lambda a: (lambda t: t.to(torch.bfloat16) if t.is_floating_point() else t)(torch.as_tensor(a)))
    B, S, C = 1024, 4, 576
    K = 3
    return {
        "x": _w((lambda *s: torch.randn(*s, dtype=torch.bfloat16) * 0.05)(B, S, C)),
        "w": _w((lambda *s: torch.randn(*s, dtype=torch.bfloat16) * 0.05)(K, C, C) * (1.0 / (K * C) ** 0.5)),
        "mean": _w((lambda *s: torch.randn(*s, dtype=torch.bfloat16) * 0.05)(C) * 0.1),
        "var": _w(torch.abs((lambda *s: torch.randn(*s, dtype=torch.bfloat16) * 0.05)(C)) + 0.5),
        "g": _w((lambda *s: torch.randn(*s, dtype=torch.bfloat16) * 0.05)(C) + 1.0),
        "b": _w((lambda *s: torch.randn(*s, dtype=torch.bfloat16) * 0.05)(C) * 0.1),
    }

def reference(x, w, mean, var, g, b):
    K = 3
    P = K // 2
    S = x.shape[1]
    xp = _pad(x, ((0, 0), (P, P), (0, 0)))
    y = sum(torch.einsum('bsc,cd->bsd', xp[:, k:k + S, :], w[k]) for k in range(K))
    inv_std = 1.0 / torch.sqrt(var + 1e-5)
    y = (y - mean) * (g * inv_std) + b
    return _silu(y)
```

```asm
; @launch grid=(256,1,1) block=(512,1,1) lds=135680
.amdgcn_target "amdgcn-amd-amdhsa--gfx950"
.text
.p2align 12
.fill 832, 4, 0xbf810000
.globl standalone__batchnorm__sampling_kernel
.p2align 8
.type standalone__batchnorm__sampling_kernel,@function
standalone__batchnorm__sampling_kernel:
    s_load_dwordx4 s[4:7], s[0:1], 0
    v_lshrrev_b32 v1, 6, v0
    s_cmp_ge_u32 s2, 256
    s_cbranch_scc1 L_exit
    v_readfirstlane_b32 s20, v1
    v_and_b32 v1, 63, v0
    s_lshr_b32 s41, s2, 3
    s_and_b32 s42, s2, 7
    s_lshr_b32 s43, 90, s42
    s_and_b32 s43, s43, 1
    s_mov_b32 s27, 0x20000
    s_mov_b32 s31, s27
    s_mov_b32 s26, 4718592
    s_lshl_b32 s44, s42, 2
    s_lshr_b32 s44, 591667747, s44
    s_and_b32 s44, s44, 15
    s_lshl_b32 s42, s42, 3
    s_cmp_lt_u32 s41, s44
    s_cbranch_scc1 L_prefetch
    s_mov_b32 s44, 1564418565
    s_mov_b32 s45, 1564418308
    s_lshr_b64 s[44:45], s[44:45], s42
    s_and_b32 s45, s44, 0xff
    s_add_u32 s45, s45, s41
    s_sub_u32 s45, s45, 8
    s_mul_i32 s46, s45, 57
    s_lshr_b32 s46, s46, 9
    s_mul_i32 s47, s46, 9
    s_sub_u32 s47, s45, s47
    s_add_u32 s48, s47, s43
    s_cmp_ge_u32 s48, 5
    s_addc_u32 s21, s46, s46
    s_and_b32 s49, s21, 1
    s_sub_u32 s49, s43, s49
    s_mul_i32 s49, s49, 5
    s_add_u32 s22, s47, s49
    s_mul_i32 s50, s21, 184320
    s_lshl_b32 s51, s22, 7
    s_cmp_lt_u32 s20, 4
    s_cbranch_scc1 L_loader
    s_cmp_eq_u32 s20, 7
    s_cbranch_scc1 L_stub
    s_branch L_compute
L_prefetch:
    s_cmp_lg_u32 s20, 0
    s_cbranch_scc1 L_exit
    s_mov_b32 s44, 302843648
    s_mov_b32 s45, 336529667
    s_lshr_b64 s[44:45], s[44:45], s42
    s_and_b32 s45, s44, 0xff
    s_add_u32 s45, s45, s41
    s_mul_i32 s46, s45, 192
    v_add_u32 v2, s46, v1
    v_mul_u32_u24 v2, 1152, v2
    v_add_u32 v3, 73728, v2
    v_add_u32 v4, 147456, v2
    v_bfrev_b32 v6, 1
    s_mul_i32 s46, s45, 27*128
    v_cmp_gt_u32 vcc, 27, v1
    v_lshl_add_u32 v5, v1, 7, s46
    s_mov_b32 s30, 1990656
    s_mov_b32 s45, 414770
    v_cndmask_b32 v5, v6, v5, vcc
    s_waitcnt lgkmcnt(0)
    s_mov_b64 s[24:25], s[4:5]
    s_mov_b64 s[28:29], s[6:7]
    s_mov_b32 s48, 0
    buffer_load_dword v8, v5, s[28:31], s48 offen
    s_mov_b32 s48, 663552
    buffer_load_dword v8, v5, s[28:31], s48 offen
    s_mov_b32 s48, 1327104
    buffer_load_dword v8, v5, s[28:31], s48 offen
L_pfl:
    s_and_b32 s47, s45, 15
    s_lshl_b32 s46, s47, 7
    s_mul_i32 s47, s47, 73728
    buffer_load_dword v8, v2, s[24:27], s46 offen
    s_add_u32 s48, s47, 663552
    buffer_load_dword v8, v3, s[24:27], s46 offen
    s_add_u32 s49, s47, 1327104
    buffer_load_dword v8, v4, s[24:27], s46 offen
    s_lshr_b32 s45, s45, 4
    buffer_load_dword v8, v5, s[28:31], s47 offen
    buffer_load_dword v8, v5, s[28:31], s48 offen
    buffer_load_dword v8, v5, s[28:31], s49 offen
    s_cbranch_scc1 L_pfl
L_exit:
    s_endpgm
L_loader:
    s_setprio 3
    s_lshr_b32 s53, s20, 1
    s_and_b32 s54, s20, 1
    v_lshrrev_b32 v4, 3, v1
    v_and_b32 v5, 7, v1
    v_lshl_add_u32 v6, s54, 3, v4
    v_lshrrev_b32 v7, 1, v6
    v_xor_b32 v7, v7, v5
    s_mul_i32 s55, s53, 92160
    s_add_u32 s55, s55, s50
    v_lshl_add_u32 v7, v7, 4, s55
    s_movk_i32 s52, 4608
    v_mad_u32_u24 v10, v6, s52, v7
    s_movk_i32 s53, 128
    v_add_u32 v11, s53, v10
    v_add_u32 v12, s53, v11
    v_add_u32 v13, s53, v12
    s_mul_i32 m0, s20, 11264
    s_movk_i32 s33, 4096
    s_mov_b32 s46, 0
    s_waitcnt lgkmcnt(0)
    s_mov_b64 s[24:25], s[4:5]
    buffer_load_dwordx4 v10, s[24:27], s46 offen offset:0 lds
    s_load_dwordx8 s[8:15], s[0:1], 16
    v_and_or_b32 v8, v6, 3, 16
    v_mad_u32_u24 v7, v8, s52, v7
    v_lshrrev_b32 v8, 2, v6
    s_movk_i32 s52, 1152
    v_mad_u32_u24 v14, v8, s52, v7
    v_lshrrev_b32 v7, 2, v1
    v_and_b32 v7, 4, v7
    s_lshl_b32 s55, s54, 1
    buffer_load_dwordx4 v11, s[24:27], s46 offen offset:1024 lds
    v_xor_b32 v7, v7, v5
    v_xor_b32 v7, s55, v7
    v_lshl_add_u32 v7, v7, 4, s51
    v_lshl_add_u32 v8, s20, 3, v4
    v_mad_u32_u24 v7, v8, s52, v7
    s_sub_u32 s28, s6, s33
    s_subb_u32 s29, s7, 0
    s_mov_b32 s30, 1994752
    s_mov_b32 s47, 0
    buffer_load_dwordx4 v12, s[24:27], s46 offen offset:2048 lds
    v_add_u32 v15, 3072, v7
    v_add_u32 v16, 665600, v7
    v_add_u32 v17, 1328128, v7
    v_add_u32 v18, 40960, v7
    v_add_u32 v19, 703488, v7
    v_add_u32 v20, 1366016, v7
    buffer_load_dwordx4 v13, s[24:27], s46 offen offset:3072 lds
    s_add_u32 m0, m0, s33
    s_lshl2_add_u32 s36, s22, s20
    s_mul_i32 s36, s36, 9
    s_lshr_b32 s36, s36, 1
    s_mul_i32 s36, s36, s52
    s_add_u32 s36, s36, s50
    s_min_u32 s36, s36, 4712832
    s_min_u32 s48, s21, 23
    buffer_load_dwordx4 v14, s[24:27], s46 offen offset:0 lds
    s_lshr_b32 s37, s48, 3
    s_lshl_b32 s37, s37, 8
    s_lshl2_add_u32 s48, s48, s20
    s_add_u32 s37, s37, s48
    s_mul_i32 s37, s37, 2304
    s_add_u32 s37, s37, s51
    s_mov_b32 s34, 36864
    s_mov_b32 s35, 73728
    s_cmp_lg_u32 s20, 0
    s_cbranch_scc1 L_np
    v_lshl_add_u32 v9, v1, 1, s51
    s_waitcnt lgkmcnt(0)
    global_load_ushort v30, v9, s[8:9]
    global_load_ushort v31, v9, s[10:11]
    global_load_ushort v32, v9, s[12:13]
    global_load_ushort v33, v9, s[14:15]
L_np:
    buffer_load_dwordx4 v15, s[28:31], s47 offen offset:1024 lds
    buffer_load_dwordx4 v16, s[28:31], s47 offen offset:2048 lds
    buffer_load_dwordx4 v17, s[28:31], s47 offen offset:3072 lds
    s_add_u32 m0, m0, s33
    s_addk_i32 s46, 128
    s_setprio 2
    buffer_load_dwordx4 v18, s[28:31], s47 offen offset:0 lds
    buffer_load_dwordx4 v19, s[28:31], s47 offen offset:1024 lds
    s_buffer_load_dwordx2 s[84:85], s[24:27], s36 offset:188
    s_buffer_load_dwordx2 s[84:85], s[24:27], s36 offset:1340
    s_buffer_load_dwordx2 s[84:85], s[24:27], s36 offset:2492
    s_buffer_load_dwordx2 s[84:85], s[24:27], s36 offset:3644
    s_buffer_load_dwordx2 s[84:85], s[24:27], s36 offset:4796
    s_buffer_load_dwordx2 s[84:85], s[28:31], s37 offset:77884
    s_buffer_load_dwordx2 s[84:85], s[28:31], s37 offset:79036
    buffer_load_dwordx4 v20, s[28:31], s47 offen offset:2048 lds
    s_add_u32 m0, m0, s34
    s_add_u32 s47, s47, s35
    s_setprio 1
    buffer_load_dwordx4 v10, s[24:27], s46 offen offset:0 lds
    buffer_load_dwordx4 v11, s[24:27], s46 offen offset:1024 lds
    buffer_load_dwordx4 v12, s[24:27], s46 offen offset:2048 lds
    buffer_load_dwordx4 v13, s[24:27], s46 offen offset:3072 lds
    s_add_u32 m0, m0, s33
    s_nop 0
    buffer_load_dwordx4 v14, s[24:27], s46 offen offset:0 lds
    s_waitcnt vmcnt(8)
    s_barrier
    buffer_load_dwordx4 v15, s[28:31], s47 offen offset:1024 lds
    buffer_load_dwordx4 v16, s[28:31], s47 offen offset:2048 lds
    buffer_load_dwordx4 v17, s[28:31], s47 offen offset:3072 lds
    s_add_u32 m0, m0, s33
    s_addk_i32 s46, 128
    s_setprio 0
    buffer_load_dwordx4 v18, s[28:31], s47 offen offset:0 lds
    buffer_load_dwordx4 v19, s[28:31], s47 offen offset:1024 lds
    buffer_load_dwordx4 v20, s[28:31], s47 offen offset:2048 lds
    s_add_u32 m0, m0, s34
    s_add_u32 s47, s47, s35
    s_waitcnt vmcnt(11)
    s_barrier
    buffer_load_dwordx4 v10, s[24:27], s46 offen offset:0 lds
    buffer_load_dwordx4 v11, s[24:27], s46 offen offset:1024 lds
    buffer_load_dwordx4 v12, s[24:27], s46 offen offset:2048 lds
    buffer_load_dwordx4 v13, s[24:27], s46 offen offset:3072 lds
    s_add_u32 m0, m0, s33
    s_nop 0
    buffer_load_dwordx4 v14, s[24:27], s46 offen offset:0 lds
    s_add_u32 s23, s21, s22
    s_and_b32 s23, s23, 3
    s_cmp_lg_u32 s20, 0
    s_cbranch_scc1 L_nopar
    v_lshlrev_b32 v31, 16, v31
    v_add_f32 v31, 0x3727c5ac, v31
    v_cvt_pk_bf16_f32 v31, v31, v31
    v_lshlrev_b32 v31, 16, v31
    v_sqrt_f32 v31, v31
    v_lshlrev_b32 v30, 16, v30
    v_cvt_pk_bf16_f32 v31, v31, v31
    v_lshlrev_b32 v31, 16, v31
    v_rcp_f32 v31, v31
    v_lshlrev_b32 v32, 16, v32
    v_cvt_pk_bf16_f32 v31, v31, v31
    v_lshlrev_b32 v31, 16, v31
    v_mul_f32 v31, v31, v32
    v_cvt_pk_bf16_f32 v31, v31, v31
    v_lshlrev_b32 v31, 16, v31
    v_lshlrev_b32 v33, 16, v33
    v_fma_f32 v33, -v30, v31, v33
    v_mul_f32 v31, 3216550459, v31
    v_mul_f32 v33, 3216550459, v33
    v_lshlrev_b32 v30, 2, v1
    v_add_u32 v30, 135168, v30
L_nopar:
    s_waitcnt vmcnt(8)
    s_barrier
    buffer_load_dwordx4 v15, s[28:31], s47 offen offset:1024 lds
    buffer_load_dwordx4 v16, s[28:31], s47 offen offset:2048 lds
    buffer_load_dwordx4 v17, s[28:31], s47 offen offset:3072 lds
    s_add_u32 m0, m0, s33
    s_addk_i32 s46, 128
    buffer_load_dwordx4 v18, s[28:31], s47 offen offset:0 lds
    buffer_load_dwordx4 v19, s[28:31], s47 offen offset:1024 lds
    s_cmp_lg_u32 s23, 0
    s_cbranch_scc1 L_site0
    s_waitcnt vmcnt(3)
    s_cmp_lg_u32 s20, 0
    s_cbranch_scc1 L_site0
    ds_write2_b32 v30, v31, v33 offset1:64
L_site0:
    s_waitcnt vmcnt(10)
    s_barrier
    buffer_load_dwordx4 v20, s[28:31], s47 offen offset:2048 lds
    s_sub_u32 m0, m0, 98304
    s_add_u32 s47, s47, s35
    buffer_load_dwordx4 v10, s[24:27], s46 offen offset:0 lds
    buffer_load_dwordx4 v11, s[24:27], s46 offen offset:1024 lds
    buffer_load_dwordx4 v12, s[24:27], s46 offen offset:2048 lds
    buffer_load_dwordx4 v13, s[24:27], s46 offen offset:3072 lds
    s_add_u32 m0, m0, s33
    s_nop 0
    buffer_load_dwordx4 v14, s[24:27], s46 offen offset:0 lds
    s_cmp_lg_u32 s23, 1
    s_cbranch_scc1 L_site1
    s_waitcnt vmcnt(3)
    s_cmp_lg_u32 s20, 0
    s_cbranch_scc1 L_site1
    ds_write2_b32 v30, v31, v33 offset1:64
L_site1:
    s_waitcnt vmcnt(8)
    s_barrier
    buffer_load_dwordx4 v15, s[28:31], s47 offen offset:1024 lds
    buffer_load_dwordx4 v16, s[28:31], s47 offen offset:2048 lds
    buffer_load_dwordx4 v17, s[28:31], s47 offen offset:3072 lds
    s_add_u32 m0, m0, s33
    s_addk_i32 s46, 128
    buffer_load_dwordx4 v18, s[28:31], s47 offen offset:0 lds
    buffer_load_dwordx4 v19, s[28:31], s47 offen offset:1024 lds
    buffer_load_dwordx4 v20, s[28:31], s47 offen offset:2048 lds
    s_add_u32 m0, m0, s34
    s_add_u32 s47, s47, s35
    s_cmp_lg_u32 s23, 2
    s_cbranch_scc1 L_site2
    s_waitcnt vmcnt(3)
    s_cmp_lg_u32 s20, 0
    s_cbranch_scc1 L_site2
    ds_write2_b32 v30, v31, v33 offset1:64
L_site2:
    s_waitcnt vmcnt(11)
    s_barrier
    buffer_load_dwordx4 v10, s[24:27], s46 offen offset:0 lds
    buffer_load_dwordx4 v11, s[24:27], s46 offen offset:1024 lds
    buffer_load_dwordx4 v12, s[24:27], s46 offen offset:2048 lds
    buffer_load_dwordx4 v13, s[24:27], s46 offen offset:3072 lds
    s_add_u32 m0, m0, s33
    s_nop 0
    buffer_load_dwordx4 v14, s[24:27], s46 offen offset:0 lds
    buffer_load_dwordx4 v15, s[28:31], s47 offen offset:1024 lds
    s_cmp_lg_u32 s23, 3
    s_cbranch_scc1 L_site3
    s_waitcnt vmcnt(3)
    s_cmp_lg_u32 s20, 0
    s_cbranch_scc1 L_site3
    ds_write2_b32 v30, v31, v33 offset1:64
L_site3:
    s_waitcnt vmcnt(9)
    s_barrier
    buffer_load_dwordx4 v16, s[28:31], s47 offen offset:2048 lds
    buffer_load_dwordx4 v17, s[28:31], s47 offen offset:3072 lds
    s_add_u32 m0, m0, s33
    s_addk_i32 s46, 128
    buffer_load_dwordx4 v18, s[28:31], s47 offen offset:0 lds
    buffer_load_dwordx4 v19, s[28:31], s47 offen offset:1024 lds
    buffer_load_dwordx4 v20, s[28:31], s47 offen offset:2048 lds
    s_add_u32 m0, m0, s34
    s_add_u32 s47, s47, s35
    s_waitcnt vmcnt(11) lgkmcnt(0)
    s_barrier
    buffer_load_dwordx4 v10, s[24:27], s46 offen offset:0 lds
    buffer_load_dwordx4 v11, s[24:27], s46 offen offset:1024 lds
    s_buffer_load_dwordx2 s[84:85], s[24:27], s36 offset:956
    buffer_load_dwordx4 v12, s[24:27], s46 offen offset:2048 lds
    buffer_load_dwordx4 v13, s[24:27], s46 offen offset:3072 lds
    s_add_u32 m0, m0, s33
    s_buffer_load_dwordx2 s[84:85], s[24:27], s36 offset:2108
    buffer_load_dwordx4 v14, s[24:27], s46 offen offset:0 lds
    buffer_load_dwordx4 v15, s[28:31], s47 offen offset:1024 lds
    s_buffer_load_dwordx2 s[84:85], s[24:27], s36 offset:3260
    s_waitcnt vmcnt(9)
    s_barrier
    buffer_load_dwordx4 v16, s[28:31], s47 offen offset:2048 lds
    buffer_load_dwordx4 v17, s[28:31], s47 offen offset:3072 lds
    s_add_u32 m0, m0, s33
    s_addk_i32 s46, 128
    s_buffer_load_dwordx2 s[84:85], s[24:27], s36 offset:4412
    buffer_load_dwordx4 v18, s[28:31], s47 offen offset:0 lds
    buffer_load_dwordx4 v19, s[28:31], s47 offen offset:1024 lds
    s_buffer_load_dwordx2 s[84:85], s[24:27], s36 offset:5564
    buffer_load_dwordx4 v20, s[28:31], s47 offen offset:2048 lds
    s_sub_u32 m0, m0, 98304
    s_add_u32 s47, s47, s35
    s_waitcnt vmcnt(11)
    s_barrier
    buffer_load_dwordx4 v10, s[24:27], s46 offen offset:0 lds
    s_buffer_load_dwordx2 s[84:85], s[28:31], s37 offset:520252
    buffer_load_dwordx4 v11, s[24:27], s46 offen offset:1024 lds
    buffer_load_dwordx4 v12, s[24:27], s46 offen offset:2048 lds
    s_buffer_load_dwordx2 s[84:85], s[28:31], s37 offset:521404
    buffer_load_dwordx4 v13, s[24:27], s46 offen offset:3072 lds
    s_add_u32 m0, m0, s33
    s_nop 0
    buffer_load_dwordx4 v14, s[24:27], s46 offen offset:0 lds
    s_buffer_load_dwordx2 s[84:85], s[24:27], s36 offset:1084
    buffer_load_dwordx4 v15, s[28:31], s47 offen offset:1024 lds
    s_waitcnt vmcnt(9)
    s_barrier
    buffer_load_dwordx4 v16, s[28:31], s47 offen offset:2048 lds
    s_buffer_load_dwordx2 s[84:85], s[24:27], s36 offset:2236
    buffer_load_dwordx4 v17, s[28:31], s47 offen offset:3072 lds
    s_add_u32 m0, m0, s33
    s_addk_i32 s46, 128
    buffer_load_dwordx4 v18, s[28:31], s47 offen offset:0 lds
    s_buffer_load_dwordx2 s[84:85], s[24:27], s36 offset:3388
    buffer_load_dwordx4 v19, s[28:31], s47 offen offset:1024 lds
    buffer_load_dwordx4 v20, s[28:31], s47 offen offset:2048 lds
    s_add_u32 m0, m0, s34
    s_add_u32 s47, s47, s35
    s_buffer_load_dwordx2 s[84:85], s[24:27], s36 offset:4540
    s_waitcnt vmcnt(11)
    s_barrier
    buffer_load_dwordx4 v10, s[24:27], s46 offen offset:0 lds
    buffer_load_dwordx4 v11, s[24:27], s46 offen offset:1024 lds
    s_buffer_load_dwordx2 s[84:85], s[24:27], s36 offset:5692
    buffer_load_dwordx4 v12, s[24:27], s46 offen offset:2048 lds
    buffer_load_dwordx4 v13, s[24:27], s46 offen offset:3072 lds
    s_add_u32 m0, m0, s33
    s_buffer_load_dwordx2 s[84:85], s[28:31], s37 offset:593980
    buffer_load_dwordx4 v14, s[24:27], s46 offen offset:0 lds
    buffer_load_dwordx4 v15, s[28:31], s47 offen offset:1024 lds
    s_buffer_load_dwordx2 s[84:85], s[28:31], s37 offset:595132
    s_waitcnt vmcnt(9)
    s_barrier
    buffer_load_dwordx4 v16, s[28:31], s47 offen offset:2048 lds
    buffer_load_dwordx4 v17, s[28:31], s47 offen offset:3072 lds
    s_add_u32 m0, m0, s33
    s_addk_i32 s46, 128
    buffer_load_dwordx4 v18, s[28:31], s47 offen offset:0 lds
    buffer_load_dwordx4 v19, s[28:31], s47 offen offset:1024 lds
    buffer_load_dwordx4 v20, s[28:31], s47 offen offset:2048 lds
    s_add_u32 m0, m0, s34
    s_add_u32 s47, s47, s35
    s_waitcnt vmcnt(11)
    s_barrier
    buffer_load_dwordx4 v10, s[24:27], s46 offen offset:0 lds
    buffer_load_dwordx4 v11, s[24:27], s46 offen offset:1024 lds
    s_add_u32 m0, m0, 4096
    s_nop 0
    buffer_load_dwordx4 v16, s[28:31], s47 offen offset:2048 lds
    buffer_load_dwordx4 v17, s[28:31], s47 offen offset:3072 lds
    s_add_u32 m0, m0, 4096
    s_nop 0
    buffer_load_dwordx4 v19, s[28:31], s47 offen offset:1024 lds
    buffer_load_dwordx4 v20, s[28:31], s47 offen offset:2048 lds
    s_waitcnt vmcnt(9)
    s_barrier
    buffer_load_dwordx4 v18, s[28:31], s47 offen offset:0 lds
    s_add_u32 m0, m0, 4294963200
    s_nop 0
    buffer_load_dwordx4 v15, s[28:31], s47 offen offset:1024 lds
    s_add_u32 m0, m0, 4294963200
    s_nop 0
    buffer_load_dwordx4 v12, s[24:27], s46 offen offset:2048 lds
    buffer_load_dwordx4 v13, s[24:27], s46 offen offset:3072 lds
    s_add_u32 m0, m0, 4096
    s_nop 0
    buffer_load_dwordx4 v14, s[24:27], s46 offen offset:0 lds
    s_waitcnt vmcnt(11)
    s_barrier
    s_waitcnt vmcnt(5)
    s_barrier
    s_waitcnt vmcnt(0)
    s_barrier
    s_endpgm
L_compute:
    s_load_dwordx2 s[16:17], s[0:1], 48
    s_bfe_u32 s52, s20, 0x10001
    s_and_b32 s53, s20, 1
    v_and_b32 v172, 15, v1
    v_lshrrev_b32 v173, 4, v1
    s_movk_i32 s54, 11264
    v_lshrrev_b32 v174, 3, v172
    v_and_b32 v175, 7, v172
    v_lshlrev_b32 v175, 7, v175
    v_mad_u32_u24 v175, v174, s54, v175
    v_lshrrev_b32 v176, 1, v172
    v_xor_b32 v176, v176, v173
    v_lshl_add_u32 v4, v176, 4, v175
    s_mul_i32 s55, s52, 22528
    v_add_u32 v4, s55, v4
    v_xor_b32 v5, 64, v4
    v_lshrrev_b32 v175, 2, v172
    v_lshlrev_b32 v175, 7, v175
    v_mad_u32_u24 v175, v173, s54, v175
    v_and_b32 v176, 1, v173
    v_lshl_or_b32 v174, v174, 1, v176
    s_lshl_b32 s55, s53, 1
    v_xor_b32 v174, s55, v174
    v_lshl_add_u32 v175, v174, 5, v175
    v_and_b32 v174, 3, v172
    v_lshl_add_u32 v175, v174, 3, v175
    v_add_u32 v6, 5120, v175
    v_xor_b32 v7, 32, v6
    v_lshrrev_b32 v175, 1, v173
    v_lshlrev_b32 v175, 4, v175
    v_lshl_add_u32 v175, v176, 5, v175
    s_mul_i32 s55, s52, 92160
    s_add_u32 s55, s55, s50
    s_add_u32 s55, s55, s51
    s_lshl_b32 s54, s53, 6
    s_add_u32 s55, s55, s54
    v_add_u32 v175, s55, v175
    s_movk_i32 s55, 4608
    v_mad_u32_u24 v8, v172, s55, v175
    v_mad_u32_u24 v9, v174, s55, v175
    v_lshrrev_b32 v174, 2, v172
    s_movk_i32 s55, 1152
    v_mad_u32_u24 v9, v174, s55, v9
    v_add_u32 v9, 73728, v9
    v_lshrrev_b32 v175, 1, v173
    v_bfe_u32 v177, v172, 2, 1
    v_xor_b32 v175, v175, v177
    v_lshlrev_b32 v175, 4, v175
    v_lshl_add_u32 v175, v176, 3, v175
    v_lshl_add_u32 v175, v172, 5, v175
    s_mul_i32 s54, s20, 1536
    v_add_u32 v2, s54, v175
    v_lshrrev_b32 v177, 2, v1
    v_xor_b32 v175, v173, v1
    v_and_b32 v175, 1, v175
    v_lshlrev_b32 v175, 4, v175
    v_lshl_add_u32 v175, v177, 5, v175
    v_bfe_u32 v178, v1, 1, 1
    v_mul_u32_u24 v178, 640, v178
    v_add3_u32 v3, v175, v178, s54
    v_readfirstlane_b32 s55, v8
    v_and_b32 v175, 3, v1
    s_movk_i32 s54, 4608
    v_lshl_add_u32 v175, v175, 4, s55
    v_mad_u32_u24 v11, v177, s54, v175
    s_lshl_b32 s54, s53, 7
    s_add_u32 s54, s54, 135168
    v_lshl_add_u32 v10, v173, 4, s54
    s_mov_b32 s34, s26
    s_mov_b32 s35, s27
    s_mov_b32 s36, 3216550459
    s_mov_b32 s37, s36
    s_mov_b32 s40, 0
    s_mov_b32 s41, 0
    s_mov_b32 s43, 45056
    v_mov_b64 v[12:13], 0
    v_mov_b64 v[14:15], 0
    v_mov_b64 v[16:17], 0
    v_mov_b64 v[18:19], 0
    v_mov_b64 v[20:21], 0
    v_mov_b64 v[22:23], 0
    v_mov_b64 v[24:25], 0
    v_mov_b64 v[26:27], 0
    v_mov_b64 v[28:29], 0
    v_mov_b64 v[30:31], 0
    v_mov_b64 v[32:33], 0
    v_mov_b64 v[34:35], 0
    v_mov_b64 v[36:37], 0
    v_mov_b64 v[38:39], 0
    v_mov_b64 v[40:41], 0
    v_mov_b64 v[42:43], 0
    v_mov_b64 v[44:45], 0
    v_mov_b64 v[46:47], 0
    v_mov_b64 v[48:49], 0
    v_mov_b64 v[50:51], 0
    v_mov_b64 v[52:53], 0
    v_mov_b64 v[54:55], 0
    v_mov_b64 v[56:57], 0
    v_mov_b64 v[58:59], 0
    v_mov_b64 v[60:61], 0
    v_mov_b64 v[62:63], 0
    v_mov_b64 v[64:65], 0
    v_mov_b64 v[66:67], 0
    s_waitcnt lgkmcnt(0)
    s_mov_b64 s[32:33], s[16:17]
    s_branch L_main
.p2align 12
L_stub:
    s_branch L_compute
L_main:
    s_barrier
    ds_read_b128 v[68:71], v4 offset:0
    ds_read_b64_tr_b16 v[116:117], v6 offset:1024
    ds_read_b64_tr_b16 v[118:119], v6 offset:1536
    ds_read_b128 v[72:75], v4 offset:1024
    ds_read_b64_tr_b16 v[124:125], v6 offset:2048
    ds_read_b64_tr_b16 v[126:127], v6 offset:2560
    ds_read_b64_tr_b16 v[108:109], v6 offset:0
    ds_read_b64_tr_b16 v[110:111], v6 offset:512
    ds_read_b128 v[76:79], v4 offset:2048
    ds_read_b128 v[80:83], v4 offset:3072
    ds_read_b128 v[84:87], v4 offset:4096
    s_branch L_A
    .p2align 6
L_cloop:
    v_mfma_f32_16x16x32_bf16 v[12:15], v[140:143], v[88:91], v[12:15]
    ds_read_b64_tr_b16 v[144:145], v7 offset:4096
    s_waitcnt lgkmcnt(6)
    v_mfma_f32_16x16x32_bf16 v[12:15], v[148:151], v[92:95], v[12:15]
    ds_read_b64_tr_b16 v[146:147], v7 offset:4608
    v_mfma_f32_16x16x32_bf16 v[20:23], v[140:143], v[92:95], v[20:23]
    ds_read_b64_tr_b16 v[152:153], v7 offset:5120
    s_waitcnt lgkmcnt(6)
    v_mfma_f32_16x16x32_bf16 v[20:23], v[132:135], v[88:91], v[20:23]
    ds_read_b64_tr_b16 v[154:155], v7 offset:5632
    s_waitcnt lgkmcnt(6)
    v_mfma_f32_16x16x32_bf16 v[20:23], v[148:151], v[96:99], v[20:23]
    ds_read_b64_tr_b16 v[136:137], v7 offset:3072
    v_mfma_f32_16x16x32_bf16 v[28:31], v[132:135], v[92:95], v[28:31]
    ds_read_b64_tr_b16 v[138:139], v7 offset:3584
    v_mfma_f32_16x16x32_bf16 v[28:31], v[140:143], v[96:99], v[28:31]
    s_waitcnt lgkmcnt(6)
    v_mfma_f32_16x16x32_bf16 v[28:31], v[148:151], v[100:103], v[28:31]
    v_mfma_f32_16x16x32_bf16 v[36:39], v[132:135], v[96:99], v[36:39]
    v_add_u32 v4, s42, v4
    v_mfma_f32_16x16x32_bf16 v[36:39], v[140:143], v[100:103], v[36:39]
    v_add_u32 v6, s42, v6
    v_mfma_f32_16x16x32_bf16 v[44:47], v[132:135], v[104:107], v[44:47]
    v_add_u32 v7, s42, v7
    v_mfma_f32_16x16x32_bf16 v[52:55], v[140:143], v[104:107], v[52:55]
    v_add_u32 v5, s42, v5
    v_mfma_f32_16x16x32_bf16 v[60:63], v[148:151], v[104:107], v[60:63]
    s_waitcnt lgkmcnt(0)
    v_mfma_f32_16x16x32_bf16 v[16:19], v[144:147], v[88:91], v[16:19]
    v_mfma_f32_16x16x32_bf16 v[16:19], v[152:155], v[92:95], v[16:19]
    s_barrier
    v_mfma_f32_16x16x32_bf16 v[24:27], v[144:147], v[92:95], v[24:27]
    ds_read_b128 v[68:71], v4 offset:0
    v_mfma_f32_16x16x32_bf16 v[24:27], v[136:139], v[88:91], v[24:27]
    ds_read_b64_tr_b16 v[116:117], v6 offset:1024
    v_mfma_f32_16x16x32_bf16 v[24:27], v[152:155], v[96:99], v[24:27]
    ds_read_b64_tr_b16 v[118:119], v6 offset:1536
    v_mfma_f32_16x16x32_bf16 v[32:35], v[136:139], v[92:95], v[32:35]
    ds_read_b128 v[72:75], v4 offset:1024
    v_mfma_f32_16x16x32_bf16 v[32:35], v[144:147], v[96:99], v[32:35]
    ds_read_b64_tr_b16 v[124:125], v6 offset:2048
    v_mfma_f32_16x16x32_bf16 v[32:35], v[152:155], v[100:103], v[32:35]
    ds_read_b64_tr_b16 v[126:127], v6 offset:2560
    v_mfma_f32_16x16x32_bf16 v[40:43], v[136:139], v[96:99], v[40:43]
    ds_read_b64_tr_b16 v[108:109], v6 offset:0
    v_mfma_f32_16x16x32_bf16 v[40:43], v[144:147], v[100:103], v[40:43]
    ds_read_b64_tr_b16 v[110:111], v6 offset:512
    v_mfma_f32_16x16x32_bf16 v[48:51], v[136:139], v[104:107], v[48:51]
    ds_read_b128 v[76:79], v4 offset:2048
    v_mfma_f32_16x16x32_bf16 v[56:59], v[144:147], v[104:107], v[56:59]
    ds_read_b128 v[80:83], v4 offset:3072
    v_mfma_f32_16x16x32_bf16 v[64:67], v[152:155], v[104:107], v[64:67]
    ds_read_b128 v[84:87], v4 offset:4096
L_A:
    s_waitcnt lgkmcnt(7)
    v_mfma_f32_16x16x32_bf16 v[12:15], v[116:119], v[68:71], v[12:15]
    ds_read_b64_tr_b16 v[120:121], v7 offset:1024
    s_waitcnt lgkmcnt(6)
    v_mfma_f32_16x16x32_bf16 v[12:15], v[124:127], v[72:75], v[12:15]
    ds_read_b64_tr_b16 v[122:123], v7 offset:1536
    v_mfma_f32_16x16x32_bf16 v[20:23], v[116:119], v[72:75], v[20:23]
    ds_read_b64_tr_b16 v[128:129], v7 offset:2048
    s_waitcnt lgkmcnt(6)
    v_mfma_f32_16x16x32_bf16 v[20:23], v[108:111], v[68:71], v[20:23]
    ds_read_b64_tr_b16 v[130:131], v7 offset:2560
    s_waitcnt lgkmcnt(6)
    v_mfma_f32_16x16x32_bf16 v[20:23], v[124:127], v[76:79], v[20:23]
    ds_read_b64_tr_b16 v[112:113], v7 offset:0
    v_mfma_f32_16x16x32_bf16 v[28:31], v[108:111], v[72:75], v[28:31]
    ds_read_b64_tr_b16 v[114:115], v7 offset:512
    v_mfma_f32_16x16x32_bf16 v[28:31], v[116:119], v[76:79], v[28:31]
    s_waitcnt lgkmcnt(6)
    v_mfma_f32_16x16x32_bf16 v[28:31], v[124:127], v[80:83], v[28:31]
    s_add_u32 s41, s41, 1
    v_mfma_f32_16x16x32_bf16 v[36:39], v[108:111], v[76:79], v[36:39]
    s_cmp_eq_u32 s41, 3
    v_mfma_f32_16x16x32_bf16 v[36:39], v[116:119], v[80:83], v[36:39]
    s_cselect_b32 s42, 4294877184, s43
    v_mfma_f32_16x16x32_bf16 v[44:47], v[108:111], v[84:87], v[44:47]
    v_mfma_f32_16x16x32_bf16 v[52:55], v[116:119], v[84:87], v[52:55]
    s_cselect_b32 s41, 0, s41
    v_mfma_f32_16x16x32_bf16 v[60:63], v[124:127], v[84:87], v[60:63]
    s_waitcnt lgkmcnt(0)
    v_mfma_f32_16x16x32_bf16 v[16:19], v[120:123], v[68:71], v[16:19]
    v_mfma_f32_16x16x32_bf16 v[16:19], v[128:131], v[72:75], v[16:19]
    s_barrier
    v_mfma_f32_16x16x32_bf16 v[24:27], v[120:123], v[72:75], v[24:27]
    ds_read_b128 v[88:91], v5 offset:0
    v_mfma_f32_16x16x32_bf16 v[24:27], v[112:115], v[68:71], v[24:27]
    ds_read_b64_tr_b16 v[140:141], v6 offset:4096
    v_mfma_f32_16x16x32_bf16 v[24:27], v[128:131], v[76:79], v[24:27]
    ds_read_b64_tr_b16 v[142:143], v6 offset:4608
    v_mfma_f32_16x16x32_bf16 v[32:35], v[112:115], v[72:75], v[32:35]
    ds_read_b128 v[92:95], v5 offset:1024
    v_mfma_f32_16x16x32_bf16 v[32:35], v[120:123], v[76:79], v[32:35]
    ds_read_b64_tr_b16 v[148:149], v6 offset:5120
    v_mfma_f32_16x16x32_bf16 v[32:35], v[128:131], v[80:83], v[32:35]
    ds_read_b64_tr_b16 v[150:151], v6 offset:5632
    s_add_u32 s40, s40, 1
    v_mfma_f32_16x16x32_bf16 v[40:43], v[112:115], v[76:79], v[40:43]
    ds_read_b64_tr_b16 v[132:133], v6 offset:3072
    s_cmp_lt_u32 s40, 8
    v_mfma_f32_16x16x32_bf16 v[40:43], v[120:123], v[80:83], v[40:43]
    ds_read_b64_tr_b16 v[134:135], v6 offset:3584
    v_mfma_f32_16x16x32_bf16 v[48:51], v[112:115], v[84:87], v[48:51]
    ds_read_b128 v[96:99], v5 offset:2048
    v_mfma_f32_16x16x32_bf16 v[56:59], v[120:123], v[84:87], v[56:59]
    ds_read_b128 v[100:103], v5 offset:3072
    v_mfma_f32_16x16x32_bf16 v[64:67], v[128:131], v[84:87], v[64:67]
    ds_read_b128 v[104:107], v5 offset:4096
    s_waitcnt lgkmcnt(7)
    v_mfma_f32_16x16x32_bf16 v[12:15], v[140:143], v[88:91], v[12:15]
    ds_read_b64_tr_b16 v[144:145], v7 offset:4096
    s_waitcnt lgkmcnt(6)
    v_mfma_f32_16x16x32_bf16 v[12:15], v[148:151], v[92:95], v[12:15]
    ds_read_b64_tr_b16 v[146:147], v7 offset:4608
    v_mfma_f32_16x16x32_bf16 v[20:23], v[140:143], v[92:95], v[20:23]
    ds_read_b64_tr_b16 v[152:153], v7 offset:5120
    s_waitcnt lgkmcnt(6)
    v_mfma_f32_16x16x32_bf16 v[20:23], v[132:135], v[88:91], v[20:23]
    ds_read_b64_tr_b16 v[154:155], v7 offset:5632
    s_waitcnt lgkmcnt(6)
    v_mfma_f32_16x16x32_bf16 v[20:23], v[148:151], v[96:99], v[20:23]
    ds_read_b64_tr_b16 v[136:137], v7 offset:3072
    v_mfma_f32_16x16x32_bf16 v[28:31], v[132:135], v[92:95], v[28:31]
    ds_read_b64_tr_b16 v[138:139], v7 offset:3584
    ds_read_b128 v[156:159], v10 offset:0
    v_mfma_f32_16x16x32_bf16 v[28:31], v[140:143], v[96:99], v[28:31]
    ds_read_b128 v[160:163], v10 offset:64
    s_waitcnt lgkmcnt(8)
    v_mfma_f32_16x16x32_bf16 v[28:31], v[148:151], v[100:103], v[28:31]
    ds_read_b128 v[164:167], v10 offset:256
    v_mfma_f32_16x16x32_bf16 v[36:39], v[132:135], v[96:99], v[36:39]
    v_add_u32 v4, s42, v4
    ds_read_b128 v[168:171], v10 offset:320
    v_mfma_f32_16x16x32_bf16 v[36:39], v[140:143], v[100:103], v[36:39]
    v_add_u32 v6, s42, v6
    v_mfma_f32_16x16x32_bf16 v[44:47], v[132:135], v[104:107], v[44:47]
    v_add_u32 v7, s42, v7
    v_mfma_f32_16x16x32_bf16 v[52:55], v[140:143], v[104:107], v[52:55]
    v_add_u32 v5, s42, v5
    v_mfma_f32_16x16x32_bf16 v[60:63], v[148:151], v[104:107], v[60:63]
    s_waitcnt lgkmcnt(3)
    v_mfma_f32_16x16x32_bf16 v[16:19], v[144:147], v[88:91], v[16:19]
    s_waitcnt lgkmcnt(0)
    v_mfma_f32_16x16x32_bf16 v[16:19], v[152:155], v[92:95], v[16:19]
    s_barrier
    v_mfma_f32_16x16x32_bf16 v[24:27], v[144:147], v[92:95], v[24:27]
    ds_read_b128 v[68:71], v4 offset:0
    v_mfma_f32_16x16x32_bf16 v[24:27], v[136:139], v[88:91], v[24:27]
    ds_read_b64_tr_b16 v[116:117], v6 offset:1024
    v_mfma_f32_16x16x32_bf16 v[24:27], v[152:155], v[96:99], v[24:27]
    ds_read_b64_tr_b16 v[118:119], v6 offset:1536
    v_mfma_f32_16x16x32_bf16 v[32:35], v[136:139], v[92:95], v[32:35]
    ds_read_b128 v[72:75], v4 offset:1024
    v_mfma_f32_16x16x32_bf16 v[32:35], v[144:147], v[96:99], v[32:35]
    ds_read_b64_tr_b16 v[124:125], v6 offset:2048
    v_mfma_f32_16x16x32_bf16 v[32:35], v[152:155], v[100:103], v[32:35]
    ds_read_b64_tr_b16 v[126:127], v6 offset:2560
    v_mfma_f32_16x16x32_bf16 v[40:43], v[136:139], v[96:99], v[40:43]
    ds_read_b64_tr_b16 v[108:109], v6 offset:0
    v_mfma_f32_16x16x32_bf16 v[40:43], v[144:147], v[100:103], v[40:43]
    ds_read_b64_tr_b16 v[110:111], v6 offset:512
    v_mfma_f32_16x16x32_bf16 v[48:51], v[136:139], v[104:107], v[48:51]
    ds_read_b128 v[76:79], v4 offset:2048
    v_mfma_f32_16x16x32_bf16 v[56:59], v[144:147], v[104:107], v[56:59]
    ds_read_b128 v[80:83], v4 offset:3072
    v_mfma_f32_16x16x32_bf16 v[64:67], v[152:155], v[104:107], v[64:67]
    ds_read_b128 v[84:87], v4 offset:4096
    s_waitcnt lgkmcnt(7)
    v_mfma_f32_16x16x32_bf16 v[12:15], v[116:119], v[68:71], v[12:15]
    ds_read_b64_tr_b16 v[120:121], v7 offset:1024
    s_waitcnt lgkmcnt(6)
    v_mfma_f32_16x16x32_bf16 v[12:15], v[124:127], v[72:75], v[12:15]
    ds_read_b64_tr_b16 v[122:123], v7 offset:1536
    v_mfma_f32_16x16x32_bf16 v[20:23], v[116:119], v[72:75], v[20:23]
    ds_read_b64_tr_b16 v[128:129], v7 offset:2048
    s_waitcnt lgkmcnt(6)
    v_mfma_f32_16x16x32_bf16 v[20:23], v[108:111], v[68:71], v[20:23]
    ds_read_b64_tr_b16 v[130:131], v7 offset:2560
    s_waitcnt lgkmcnt(6)
    v_mfma_f32_16x16x32_bf16 v[20:23], v[124:127], v[76:79], v[20:23]
    ds_read_b64_tr_b16 v[112:113], v7 offset:0
    v_mfma_f32_16x16x32_bf16 v[28:31], v[108:111], v[72:75], v[28:31]
    ds_read_b64_tr_b16 v[114:115], v7 offset:512
    v_mfma_f32_16x16x32_bf16 v[28:31], v[116:119], v[76:79], v[28:31]
    s_waitcnt lgkmcnt(6)
    v_mfma_f32_16x16x32_bf16 v[28:31], v[124:127], v[80:83], v[28:31]
    s_add_u32 s41, s41, 1
    v_mfma_f32_16x16x32_bf16 v[36:39], v[108:111], v[76:79], v[36:39]
    s_cmp_eq_u32 s41, 3
    v_mfma_f32_16x16x32_bf16 v[36:39], v[116:119], v[80:83], v[36:39]
    s_cselect_b32 s42, 4294877184, s43
    v_mfma_f32_16x16x32_bf16 v[44:47], v[108:111], v[84:87], v[44:47]
    v_mfma_f32_16x16x32_bf16 v[52:55], v[116:119], v[84:87], v[52:55]
    s_cselect_b32 s41, 0, s41
    v_mfma_f32_16x16x32_bf16 v[60:63], v[124:127], v[84:87], v[60:63]
    s_waitcnt lgkmcnt(0)
    v_mfma_f32_16x16x32_bf16 v[16:19], v[120:123], v[68:71], v[16:19]
    v_mfma_f32_16x16x32_bf16 v[16:19], v[128:131], v[72:75], v[16:19]
    s_barrier
    v_mfma_f32_16x16x32_bf16 v[24:27], v[120:123], v[72:75], v[24:27]
    ds_read_b128 v[88:91], v5 offset:0
    v_mfma_f32_16x16x32_bf16 v[24:27], v[112:115], v[68:71], v[24:27]
    ds_read_b64_tr_b16 v[140:141], v6 offset:4096
    v_mfma_f32_16x16x32_bf16 v[24:27], v[128:131], v[76:79], v[24:27]
    ds_read_b64_tr_b16 v[142:143], v6 offset:4608
    v_mfma_f32_16x16x32_bf16 v[32:35], v[112:115], v[72:75], v[32:35]
    ds_read_b128 v[92:95], v5 offset:1024
    v_mfma_f32_16x16x32_bf16 v[32:35], v[120:123], v[76:79], v[32:35]
    ds_read_b64_tr_b16 v[148:149], v6 offset:5120
    v_mfma_f32_16x16x32_bf16 v[32:35], v[128:131], v[80:83], v[32:35]
    ds_read_b64_tr_b16 v[150:151], v6 offset:5632
    s_add_u32 s40, s40, 1
    v_mfma_f32_16x16x32_bf16 v[40:43], v[112:115], v[76:79], v[40:43]
    ds_read_b64_tr_b16 v[132:133], v6 offset:3072
    s_cmp_lt_u32 s40, 8
    v_mfma_f32_16x16x32_bf16 v[40:43], v[120:123], v[80:83], v[40:43]
    ds_read_b64_tr_b16 v[134:135], v6 offset:3584
    v_mfma_f32_16x16x32_bf16 v[48:51], v[112:115], v[84:87], v[48:51]
    ds_read_b128 v[96:99], v5 offset:2048
    v_mfma_f32_16x16x32_bf16 v[56:59], v[120:123], v[84:87], v[56:59]
    ds_read_b128 v[100:103], v5 offset:3072
    s_waitcnt lgkmcnt(6)
    v_mfma_f32_16x16x32_bf16 v[64:67], v[128:131], v[84:87], v[64:67]
    ds_read_b128 v[104:107], v5 offset:4096
    s_cbranch_scc1 L_cloop
    v_mfma_f32_16x16x32_bf16 v[12:15], v[140:143], v[88:91], v[12:15]
    ds_read_b64_tr_b16 v[144:145], v7 offset:4096
    ds_read_b64_tr_b16 v[146:147], v7 offset:4608
    s_waitcnt lgkmcnt(5)
    v_mfma_f32_16x16x32_bf16 v[12:15], v[148:151], v[92:95], v[12:15]
    ds_read_b64_tr_b16 v[152:153], v7 offset:5120
    v_add_u32 v4, s42, v4
    v_mfma_f32_16x16x32_bf16 v[20:23], v[140:143], v[92:95], v[20:23]
    ds_read_b64_tr_b16 v[154:155], v7 offset:5632
    v_add_u32 v6, s42, v6
    v_mfma_f32_16x16x32_bf16 v[20:23], v[132:135], v[88:91], v[20:23]
    ds_read_b64_tr_b16 v[136:137], v7 offset:3072
    ds_read_b64_tr_b16 v[138:139], v7 offset:3584
    s_waitcnt lgkmcnt(6)
    v_mfma_f32_16x16x32_bf16 v[20:23], v[148:151], v[96:99], v[20:23]
    v_add_u32 v5, s42, v5
    v_add_u32 v7, s42, v7
    v_mfma_f32_16x16x32_bf16 v[44:47], v[132:135], v[104:107], v[44:47]
    s_barrier
    ds_read_b128 v[68:71], v4 offset:0
    v_mfma_f32_16x16x32_bf16 v[52:55], v[140:143], v[104:107], v[52:55]
    ds_read_b64_tr_b16 v[116:117], v6 offset:1024
    ds_read_b64_tr_b16 v[118:119], v6 offset:1536
    v_mfma_f32_16x16x32_bf16 v[60:63], v[148:151], v[104:107], v[60:63]
    ds_read_b128 v[72:75], v4 offset:1024
    s_waitcnt lgkmcnt(4)
    v_mfma_f32_16x16x32_bf16 v[16:19], v[144:147], v[88:91], v[16:19]
    ds_read_b64_tr_b16 v[124:125], v6 offset:2048
    ds_read_b64_tr_b16 v[126:127], v6 offset:2560
    v_mfma_f32_16x16x32_bf16 v[16:19], v[152:155], v[92:95], v[16:19]
    ds_read_b128 v[200:203], v5 offset:0
    v_mfma_f32_16x16x32_bf16 v[24:27], v[144:147], v[92:95], v[24:27]
    ds_read_b64_tr_b16 v[228:229], v6 offset:4096
    ds_read_b64_tr_b16 v[230:231], v6 offset:4608
    v_mfma_f32_16x16x32_bf16 v[24:27], v[136:139], v[88:91], v[24:27]
    ds_read_b128 v[204:207], v5 offset:1024
    v_mfma_f32_16x16x32_bf16 v[24:27], v[152:155], v[96:99], v[24:27]
    ds_read_b64_tr_b16 v[236:237], v6 offset:5120
    ds_read_b64_tr_b16 v[238:239], v6 offset:5632
    v_mfma_f32_16x16x32_bf16 v[48:51], v[136:139], v[104:107], v[48:51]
    ds_read_b64_tr_b16 v[120:121], v7 offset:1024
    v_mfma_f32_16x16x32_bf16 v[56:59], v[144:147], v[104:107], v[56:59]
    ds_read_b64_tr_b16 v[122:123], v7 offset:1536
    ds_read_b64_tr_b16 v[128:129], v7 offset:2048
    v_mfma_f32_16x16x32_bf16 v[64:67], v[152:155], v[104:107], v[64:67]
    ds_read_b64_tr_b16 v[130:131], v7 offset:2560
    s_waitcnt lgkmcnt(6)
    v_mfma_f32_16x16x32_bf16 v[12:15], v[116:119], v[68:71], v[12:15]
    ds_read_b64_tr_b16 v[232:233], v7 offset:4096
    ds_read_b64_tr_b16 v[234:235], v7 offset:4608
    v_mfma_f32_16x16x32_bf16 v[12:15], v[124:127], v[72:75], v[12:15]
    ds_read_b64_tr_b16 v[240:241], v7 offset:5120
    v_mfma_f32_16x16x32_bf16 v[12:15], v[228:231], v[200:203], v[12:15]
    ds_read_b64_tr_b16 v[242:243], v7 offset:5632
    s_waitcnt lgkmcnt(5)
    v_mfma_f32_16x16x32_bf16 v[12:15], v[236:239], v[204:207], v[12:15]
    v_mfma_f32_16x16x32_bf16 v[16:19], v[120:123], v[68:71], v[16:19]
    s_waitcnt lgkmcnt(2)
    v_mfma_f32_16x16x32_bf16 v[16:19], v[128:131], v[72:75], v[16:19]
    s_barrier
    ds_read_b64_tr_b16 v[108:109], v6 offset:0
    v_mfma_f32_16x16x32_bf16 v[16:19], v[232:235], v[200:203], v[16:19]
    ds_read_b64_tr_b16 v[110:111], v6 offset:512
    ds_read_b128 v[76:79], v4 offset:2048
    s_waitcnt lgkmcnt(3)
    v_mfma_f32_16x16x32_bf16 v[16:19], v[240:243], v[204:207], v[16:19]
    ds_read_b64_tr_b16 v[220:221], v6 offset:3072
    ds_read_b64_tr_b16 v[222:223], v6 offset:3584
    s_nop 0
    ds_read_b128 v[208:211], v5 offset:2048
    s_nop 0
    ds_read_b64_tr_b16 v[112:113], v7 offset:0
    s_nop 0
    v_pk_fma_f32 v[12:13], v[12:13], v[156:157], v[164:165]
    ds_read_b64_tr_b16 v[114:115], v7 offset:512
    v_pk_fma_f32 v[14:15], v[14:15], v[158:159], v[166:167]
    ds_read_b64_tr_b16 v[224:225], v7 offset:3072
    v_pk_fma_f32 v[16:17], v[16:17], v[160:161], v[168:169]
    ds_read_b64_tr_b16 v[226:227], v7 offset:3584
    v_pk_fma_f32 v[18:19], v[18:19], v[162:163], v[170:171]
    v_mfma_f32_16x16x32_bf16 v[20:23], v[116:119], v[72:75], v[20:23]
    v_exp_f32 v172, v12
    ds_read_b128 v[84:87], v4 offset:4096
    v_mfma_f32_16x16x32_bf16 v[20:23], v[228:231], v[204:207], v[20:23]
    v_exp_f32 v173, v13
    v_mfma_f32_16x16x32_bf16 v[24:27], v[120:123], v[72:75], v[24:27]
    v_exp_f32 v174, v14
    ds_read_b128 v[216:219], v5 offset:4096
    v_mfma_f32_16x16x32_bf16 v[24:27], v[232:235], v[204:207], v[24:27]
    v_exp_f32 v175, v15
    s_waitcnt lgkmcnt(2)
    v_mfma_f32_16x16x32_bf16 v[20:23], v[108:111], v[68:71], v[20:23]
    v_exp_f32 v176, v16
    ds_read_b128 v[80:83], v4 offset:3072
    v_mfma_f32_16x16x32_bf16 v[20:23], v[124:127], v[76:79], v[20:23]
    v_exp_f32 v177, v17
    v_exp_f32 v178, v18
    ds_read_b128 v[212:215], v5 offset:3072
    v_exp_f32 v179, v19
    v_pk_fma_f32 v[172:173], v[172:173], s[36:37], s[36:37]
    v_pk_fma_f32 v[174:175], v[174:175], s[36:37], s[36:37]
    v_pk_fma_f32 v[176:177], v[176:177], s[36:37], s[36:37]
    v_pk_fma_f32 v[178:179], v[178:179], s[36:37], s[36:37]
    v_mfma_f32_16x16x32_bf16 v[20:23], v[220:223], v[200:203], v[20:23]
    v_rcp_f32 v172, v172
    v_mfma_f32_16x16x32_bf16 v[20:23], v[236:239], v[208:211], v[20:23]
    v_rcp_f32 v173, v173
    v_mfma_f32_16x16x32_bf16 v[24:27], v[112:115], v[68:71], v[24:27]
    v_rcp_f32 v174, v174
    v_mfma_f32_16x16x32_bf16 v[24:27], v[128:131], v[76:79], v[24:27]
    v_rcp_f32 v175, v175
    v_mfma_f32_16x16x32_bf16 v[24:27], v[224:227], v[200:203], v[24:27]
    v_rcp_f32 v176, v176
    v_mfma_f32_16x16x32_bf16 v[24:27], v[240:243], v[208:211], v[24:27]
    v_rcp_f32 v177, v177
    v_rcp_f32 v178, v178
    v_rcp_f32 v179, v179
    v_pk_mul_f32 v[12:13], v[12:13], v[172:173]
    v_pk_mul_f32 v[14:15], v[14:15], v[174:175]
    v_pk_mul_f32 v[16:17], v[16:17], v[176:177]
    v_pk_mul_f32 v[18:19], v[18:19], v[178:179]
    v_cvt_pk_bf16_f32 v180, v12, v13
    v_cvt_pk_bf16_f32 v182, v16, v17
    v_cvt_pk_bf16_f32 v181, v14, v15
    v_cvt_pk_bf16_f32 v183, v18, v19
    v_permlane16_swap_b32 v180, v182
    v_pk_fma_f32 v[20:21], v[20:21], v[156:157], v[164:165]
    v_permlane16_swap_b32 v181, v183
    v_pk_fma_f32 v[22:23], v[22:23], v[158:159], v[166:167]
    v_pk_fma_f32 v[24:25], v[24:25], v[160:161], v[168:169]
    v_pk_fma_f32 v[26:27], v[26:27], v[162:163], v[170:171]
    s_waitcnt lgkmcnt(0)
    v_mfma_f32_16x16x32_bf16 v[44:47], v[108:111], v[84:87], v[44:47]
    buffer_store_dwordx4 v[180:183], v8, s[32:35], 0 offen offset:0 sc0 sc1
    v_exp_f32 v172, v20
    v_mfma_f32_16x16x32_bf16 v[44:47], v[220:223], v[216:219], v[44:47]
    v_exp_f32 v173, v21
    v_mfma_f32_16x16x32_bf16 v[52:55], v[116:119], v[84:87], v[52:55]
    v_exp_f32 v174, v22
    v_mfma_f32_16x16x32_bf16 v[52:55], v[228:231], v[216:219], v[52:55]
    v_exp_f32 v175, v23
    v_mfma_f32_16x16x32_bf16 v[60:63], v[124:127], v[84:87], v[60:63]
    v_exp_f32 v176, v24
    v_mfma_f32_16x16x32_bf16 v[60:63], v[236:239], v[216:219], v[60:63]
    v_exp_f32 v177, v25
    v_exp_f32 v178, v26
    v_exp_f32 v179, v27
    v_pk_fma_f32 v[172:173], v[172:173], s[36:37], s[36:37]
    v_pk_fma_f32 v[174:175], v[174:175], s[36:37], s[36:37]
    v_pk_fma_f32 v[176:177], v[176:177], s[36:37], s[36:37]
    v_pk_fma_f32 v[178:179], v[178:179], s[36:37], s[36:37]
    v_mfma_f32_16x16x32_bf16 v[48:51], v[112:115], v[84:87], v[48:51]
    v_rcp_f32 v172, v172
    v_mfma_f32_16x16x32_bf16 v[48:51], v[224:227], v[216:219], v[48:51]
    v_rcp_f32 v173, v173
    v_mfma_f32_16x16x32_bf16 v[56:59], v[120:123], v[84:87], v[56:59]
    v_rcp_f32 v174, v174
    v_mfma_f32_16x16x32_bf16 v[56:59], v[232:235], v[216:219], v[56:59]
    v_rcp_f32 v175, v175
    v_mfma_f32_16x16x32_bf16 v[64:67], v[128:131], v[84:87], v[64:67]
    v_rcp_f32 v176, v176
    v_mfma_f32_16x16x32_bf16 v[64:67], v[240:243], v[216:219], v[64:67]
    v_rcp_f32 v177, v177
    v_rcp_f32 v178, v178
    v_rcp_f32 v179, v179
    v_pk_mul_f32 v[20:21], v[20:21], v[172:173]
    v_pk_mul_f32 v[22:23], v[22:23], v[174:175]
    v_pk_mul_f32 v[24:25], v[24:25], v[176:177]
    v_pk_mul_f32 v[26:27], v[26:27], v[178:179]
    v_cvt_pk_bf16_f32 v184, v20, v21
    v_cvt_pk_bf16_f32 v186, v24, v25
    v_cvt_pk_bf16_f32 v185, v22, v23
    v_cvt_pk_bf16_f32 v187, v26, v27
    v_permlane16_swap_b32 v184, v186
    v_mfma_f32_16x16x32_bf16 v[28:31], v[132:135], v[92:95], v[28:31]
    v_add_f32_dpp v52, v44, v52 row_shr:4 row_mask:0xf bank_mask:0xf bound_ctrl:0
    v_permlane16_swap_b32 v185, v187
    v_add_f32_dpp v53, v45, v53 row_shr:4 row_mask:0xf bank_mask:0xf bound_ctrl:0
    v_mfma_f32_16x16x32_bf16 v[28:31], v[140:143], v[96:99], v[28:31]
    buffer_store_dwordx4 v[184:187], v8, s[32:35], 0 offen offset:1152 sc0 sc1
    v_add_f32_dpp v54, v46, v54 row_shr:4 row_mask:0xf bank_mask:0xf bound_ctrl:0
    v_add_f32_dpp v55, v47, v55 row_shr:4 row_mask:0xf bank_mask:0xf bound_ctrl:0
    v_mfma_f32_16x16x32_bf16 v[28:31], v[148:151], v[100:103], v[28:31]
    v_add_f32_dpp v56, v48, v56 row_shr:4 row_mask:0xf bank_mask:0xf bound_ctrl:0
    v_add_f32_dpp v57, v49, v57 row_shr:4 row_mask:0xf bank_mask:0xf bound_ctrl:0
    v_mfma_f32_16x16x32_bf16 v[28:31], v[108:111], v[72:75], v[28:31]
    v_add_f32_dpp v58, v50, v58 row_shr:4 row_mask:0xf bank_mask:0xf bound_ctrl:0
    v_add_f32_dpp v59, v51, v59 row_shr:4 row_mask:0xf bank_mask:0xf bound_ctrl:0
    v_mfma_f32_16x16x32_bf16 v[28:31], v[116:119], v[76:79], v[28:31]
    v_add_f32_dpp v52, v60, v52 row_shl:4 row_mask:0xf bank_mask:0xf bound_ctrl:0
    v_add_f32_dpp v53, v61, v53 row_shl:4 row_mask:0xf bank_mask:0xf bound_ctrl:0
    v_mfma_f32_16x16x32_bf16 v[28:31], v[124:127], v[80:83], v[28:31]
    v_add_f32_dpp v54, v62, v54 row_shl:4 row_mask:0xf bank_mask:0xf bound_ctrl:0
    v_add_f32_dpp v55, v63, v55 row_shl:4 row_mask:0xf bank_mask:0xf bound_ctrl:0
    v_add_f32_dpp v56, v64, v56 row_shl:4 row_mask:0xf bank_mask:0xf bound_ctrl:0
    v_add_f32_dpp v57, v65, v57 row_shl:4 row_mask:0xf bank_mask:0xf bound_ctrl:0
    v_add_f32_dpp v58, v66, v58 row_shl:4 row_mask:0xf bank_mask:0xf bound_ctrl:0
    v_add_f32_dpp v59, v67, v59 row_shl:4 row_mask:0xf bank_mask:0xf bound_ctrl:0
    v_pk_fma_f32 v[52:53], v[52:53], v[156:157], v[164:165]
    v_pk_fma_f32 v[54:55], v[54:55], v[158:159], v[166:167]
    v_pk_fma_f32 v[56:57], v[56:57], v[160:161], v[168:169]
    v_pk_fma_f32 v[58:59], v[58:59], v[162:163], v[170:171]
    v_mfma_f32_16x16x32_bf16 v[28:31], v[220:223], v[204:207], v[28:31]
    v_exp_f32 v172, v52
    v_mfma_f32_16x16x32_bf16 v[28:31], v[228:231], v[208:211], v[28:31]
    v_exp_f32 v173, v53
    v_mfma_f32_16x16x32_bf16 v[28:31], v[236:239], v[212:215], v[28:31]
    v_exp_f32 v174, v54
    v_mfma_f32_16x16x32_bf16 v[32:35], v[136:139], v[92:95], v[32:35]
    v_exp_f32 v175, v55
    v_mfma_f32_16x16x32_bf16 v[32:35], v[144:147], v[96:99], v[32:35]
    v_exp_f32 v176, v56
    v_mfma_f32_16x16x32_bf16 v[32:35], v[152:155], v[100:103], v[32:35]
    v_exp_f32 v177, v57
    v_exp_f32 v178, v58
    v_exp_f32 v179, v59
    v_pk_fma_f32 v[172:173], v[172:173], s[36:37], s[36:37]
    v_pk_fma_f32 v[174:175], v[174:175], s[36:37], s[36:37]
    v_pk_fma_f32 v[176:177], v[176:177], s[36:37], s[36:37]
    v_pk_fma_f32 v[178:179], v[178:179], s[36:37], s[36:37]
    v_mfma_f32_16x16x32_bf16 v[32:35], v[112:115], v[72:75], v[32:35]
    v_rcp_f32 v172, v172
    v_mfma_f32_16x16x32_bf16 v[32:35], v[120:123], v[76:79], v[32:35]
    v_rcp_f32 v173, v173
    v_mfma_f32_16x16x32_bf16 v[32:35], v[128:131], v[80:83], v[32:35]
    v_rcp_f32 v174, v174
    v_mfma_f32_16x16x32_bf16 v[32:35], v[224:227], v[204:207], v[32:35]
    v_rcp_f32 v175, v175
    v_mfma_f32_16x16x32_bf16 v[32:35], v[232:235], v[208:211], v[32:35]
    v_rcp_f32 v176, v176
    v_mfma_f32_16x16x32_bf16 v[32:35], v[240:243], v[212:215], v[32:35]
    v_rcp_f32 v177, v177
    v_rcp_f32 v178, v178
    v_rcp_f32 v179, v179
    v_pk_mul_f32 v[52:53], v[52:53], v[172:173]
    v_pk_mul_f32 v[54:55], v[54:55], v[174:175]
    v_pk_mul_f32 v[56:57], v[56:57], v[176:177]
    v_pk_mul_f32 v[58:59], v[58:59], v[178:179]
    v_cvt_pk_bf16_f32 v188, v52, v53
    v_cvt_pk_bf16_f32 v190, v56, v57
    v_cvt_pk_bf16_f32 v189, v54, v55
    v_cvt_pk_bf16_f32 v191, v58, v59
    v_permlane16_swap_b32 v188, v190
    v_pk_fma_f32 v[28:29], v[28:29], v[156:157], v[164:165]
    v_permlane16_swap_b32 v189, v191
    v_pk_fma_f32 v[30:31], v[30:31], v[158:159], v[166:167]
    v_pk_fma_f32 v[32:33], v[32:33], v[160:161], v[168:169]
    v_pk_fma_f32 v[34:35], v[34:35], v[162:163], v[170:171]
    v_mfma_f32_16x16x32_bf16 v[36:39], v[132:135], v[96:99], v[36:39]
    buffer_store_dwordx4 v[188:191], v9, s[32:35], 0 offen offset:0 sc0 sc1
    v_exp_f32 v172, v28
    v_mfma_f32_16x16x32_bf16 v[36:39], v[140:143], v[100:103], v[36:39]
    v_exp_f32 v173, v29
    v_mfma_f32_16x16x32_bf16 v[36:39], v[108:111], v[76:79], v[36:39]
    v_exp_f32 v174, v30
    v_mfma_f32_16x16x32_bf16 v[36:39], v[116:119], v[80:83], v[36:39]
    v_exp_f32 v175, v31
    v_mfma_f32_16x16x32_bf16 v[36:39], v[220:223], v[208:211], v[36:39]
    v_exp_f32 v176, v32
    v_mfma_f32_16x16x32_bf16 v[36:39], v[228:231], v[212:215], v[36:39]
    v_exp_f32 v177, v33
    v_exp_f32 v178, v34
    v_exp_f32 v179, v35
    v_pk_fma_f32 v[172:173], v[172:173], s[36:37], s[36:37]
    v_pk_fma_f32 v[174:175], v[174:175], s[36:37], s[36:37]
    v_pk_fma_f32 v[176:177], v[176:177], s[36:37], s[36:37]
    v_pk_fma_f32 v[178:179], v[178:179], s[36:37], s[36:37]
    v_mfma_f32_16x16x32_bf16 v[40:43], v[136:139], v[96:99], v[40:43]
    v_rcp_f32 v172, v172
    v_mfma_f32_16x16x32_bf16 v[40:43], v[144:147], v[100:103], v[40:43]
    v_rcp_f32 v173, v173
    v_mfma_f32_16x16x32_bf16 v[40:43], v[112:115], v[76:79], v[40:43]
    v_rcp_f32 v174, v174
    v_mfma_f32_16x16x32_bf16 v[40:43], v[120:123], v[80:83], v[40:43]
    v_rcp_f32 v175, v175
    v_mfma_f32_16x16x32_bf16 v[40:43], v[224:227], v[208:211], v[40:43]
    v_rcp_f32 v176, v176
    v_mfma_f32_16x16x32_bf16 v[40:43], v[232:235], v[212:215], v[40:43]
    v_rcp_f32 v177, v177
    v_rcp_f32 v178, v178
    v_rcp_f32 v179, v179
    v_pk_mul_f32 v[28:29], v[28:29], v[172:173]
    v_pk_mul_f32 v[30:31], v[30:31], v[174:175]
    v_pk_mul_f32 v[32:33], v[32:33], v[176:177]
    v_pk_mul_f32 v[34:35], v[34:35], v[178:179]
    v_cvt_pk_bf16_f32 v192, v28, v29
    v_cvt_pk_bf16_f32 v194, v32, v33
    v_cvt_pk_bf16_f32 v193, v30, v31
    v_cvt_pk_bf16_f32 v195, v34, v35
    v_permlane16_swap_b32 v192, v194
    v_pk_fma_f32 v[36:37], v[36:37], v[156:157], v[164:165]
    v_permlane16_swap_b32 v193, v195
    v_pk_fma_f32 v[38:39], v[38:39], v[158:159], v[166:167]
    buffer_store_dwordx4 v[192:195], v8, s[32:35], 0 offen offset:2304 sc0 sc1
    v_pk_fma_f32 v[40:41], v[40:41], v[160:161], v[168:169]
    v_pk_fma_f32 v[42:43], v[42:43], v[162:163], v[170:171]
    v_exp_f32 v172, v36
    v_exp_f32 v173, v37
    v_exp_f32 v174, v38
    v_exp_f32 v175, v39
    v_exp_f32 v176, v40
    v_exp_f32 v177, v41
    v_exp_f32 v178, v42
    v_exp_f32 v179, v43
    v_pk_fma_f32 v[172:173], v[172:173], s[36:37], s[36:37]
    v_pk_fma_f32 v[174:175], v[174:175], s[36:37], s[36:37]
    v_pk_fma_f32 v[176:177], v[176:177], s[36:37], s[36:37]
    v_pk_fma_f32 v[178:179], v[178:179], s[36:37], s[36:37]
    v_rcp_f32 v172, v172
    v_rcp_f32 v173, v173
    v_rcp_f32 v174, v174
    v_rcp_f32 v175, v175
    v_rcp_f32 v176, v176
    v_rcp_f32 v177, v177
    v_rcp_f32 v178, v178
    v_rcp_f32 v179, v179
    v_pk_mul_f32 v[36:37], v[36:37], v[172:173]
    v_pk_mul_f32 v[38:39], v[38:39], v[174:175]
    v_pk_mul_f32 v[40:41], v[40:41], v[176:177]
    v_pk_mul_f32 v[42:43], v[42:43], v[178:179]
    v_cvt_pk_bf16_f32 v196, v36, v37
    v_cvt_pk_bf16_f32 v197, v38, v39
    ds_write_b64 v2, v[196:197]
    v_cvt_pk_bf16_f32 v198, v40, v41
    v_cvt_pk_bf16_f32 v199, v42, v43
    ds_write_b64 v2, v[198:199] offset:640
    ds_read_b128 v[196:199], v3
    s_waitcnt lgkmcnt(0)
    buffer_store_dwordx4 v[196:199], v11, s[32:35], 0 offen offset:3456 sc0 sc1
L_end:
    s_endpgm
.section .rodata,"a"
.p2align 6
.amdhsa_kernel standalone__batchnorm__sampling_kernel
  .amdhsa_next_free_vgpr 256
  .amdhsa_next_free_sgpr 96
  .amdhsa_accum_offset 256
  .amdhsa_group_segment_fixed_size 0
  .amdhsa_kernarg_size 72
  .amdhsa_user_sgpr_count 2
  .amdhsa_user_sgpr_kernarg_segment_ptr 1
  .amdhsa_system_sgpr_workgroup_id_x 1
.end_amdhsa_kernel
```
